```python
import torch

def _softmax(x, axis=-1):
    return torch.softmax(x, dim=axis)

def _gelu(x):
    return torch.nn.functional.gelu(x, approximate='tanh')

def _silu(x):
    return torch.nn.functional.silu(x)

def _sigmoid(x):
    return torch.sigmoid(x)

def _layernorm(x, axis=-1, eps=1e-05):
    m = x.mean(dim=axis, keepdim=True)
    v = x.var(dim=axis, keepdim=True, unbiased=False)
    return (x - m) / torch.sqrt(v + eps)

def _scatter_add(tgt, idx, src, axis=0):
    return tgt.clone().index_add_(axis, idx, src)

def _segment_sum(src, seg, n):
    out = torch.zeros((n,) + src.shape[1:], dtype=src.dtype)
    return out.index_add_(0, seg, src)

def _pad(x, pw):
    flat = tuple((v for pair in reversed(pw) for v in pair))
    return torch.nn.functional.pad(x, flat)
kernel_name = 'standalone__tree_speculative_verify_tree_attention_over_candidate_token_tree__sampling'

def setup_inputs():

    _w = lambda a: (lambda t: t.to(torch.bfloat16) if t.is_floating_point() else t)(torch.as_tensor(a))
    B, Hq, Hkv, T, C, D = (32, 32, 8, 1, 2048, 128)
    tree_mask = torch.zeros((B, T, T), dtype=float)
    for b in range(B):
        parent = torch.zeros(T, dtype=torch.int64)
        for i in range(1, T):
            parent[i] = int(torch.randint(0, i, (1,)).item())
        for i in range(T):
            j = i
            tree_mask[b, i, j] = 1.0
            while j > 0:
                j = parent[j]
                tree_mask[b, i, j] = 1.0
    return {'q': _w((lambda *s: torch.randn(*s, dtype=torch.bfloat16) * 0.8)(B, Hq, T, D)), 'k_cache': _w((lambda *s: torch.randn(*s, dtype=torch.bfloat16) * 0.8)(B, Hkv, C, D)), 'v_cache': _w((lambda *s: torch.randn(*s, dtype=torch.bfloat16) * 0.05)(B, Hkv, C, D)), 'k_tree': _w((lambda *s: torch.randn(*s, dtype=torch.bfloat16) * 0.8)(B, Hkv, T, D)), 'v_tree': _w((lambda *s: torch.randn(*s, dtype=torch.bfloat16) * 0.05)(B, Hkv, T, D)), 'tree_mask': _w(tree_mask)}

def reference(q, k_cache, v_cache, k_tree, v_tree, tree_mask):
    B, Hq, T, D = q.shape
    Hkv, C = (k_cache.shape[1], k_cache.shape[2])
    rep = Hq // Hkv
    kc = (lambda x, n, axis: torch.repeat_interleave(x, n, dim=axis))(k_cache, rep, axis=1)
    vc = (lambda x, n, axis: torch.repeat_interleave(x, n, dim=axis))(v_cache, rep, axis=1)
    kt = (lambda x, n, axis: torch.repeat_interleave(x, n, dim=axis))(k_tree, rep, axis=1)
    vt = (lambda x, n, axis: torch.repeat_interleave(x, n, dim=axis))(v_tree, rep, axis=1)
    k = torch.concatenate([kc, kt], axis=2)
    v = torch.concatenate([vc, vt], axis=2)
    scale = D ** (-0.5)
    scores = torch.einsum('bhqd,bhkd->bhqk', q, k) * scale
    ctx_mask = torch.ones((B, 1, T, C), dtype=scores.dtype)
    tm = tree_mask[:, None, :, :].clone()
    full_mask = torch.concatenate([ctx_mask, tm], axis=-1)
    scores = scores + (1.0 - full_mask) * -1000000000.0
    p = _softmax(scores, axis=-1)
    return torch.einsum('bhqk,bhkd->bhqd', p, v)
```

```asm
; @launch grid=(256,1,1) block=(320,1,1) lds=90000
.amdgcn_target "amdgcn-amd-amdhsa--gfx950"
.text
.globl standalone__tree_speculative_verify_tree_attention_over_candidate_token_tree__sampling_kernel
.p2align 8
.type standalone__tree_speculative_verify_tree_attention_over_candidate_token_tree__sampling_kernel,@function
standalone__tree_speculative_verify_tree_attention_over_candidate_token_tree__sampling_kernel:
  s_load_dwordx16 s[4:19], s[0:1], 0
  s_cmp_ge_u32 s2, 256
  s_cbranch_scc1 L_end
  s_and_b32 s3, s2, 7
  s_lshr_b32 s2, s2, 3
  s_lshl_b32 s3, s3, 5
  s_or_b32 s2, s2, s3
  v_lshrrev_b32 v6, 6, v0
  v_and_b32 v0, 63, v0
  v_readfirstlane_b32 s40, v6
  v_lshrrev_b32 v7, 4, v0
  v_and_b32 v6, 15, v0
  v_lshlrev_b32 v5, 4, v6
  v_lshl_add_u32 v5, v7, 10, v5
  s_lshl_b32 s47, s2, 19
  s_and_b32 s79, s40, 1
  s_mul_i32 s79, s79, 0x2000
  s_lshr_b32 s76, s40, 1
  s_mul_i32 s76, s76, 0x41000
  s_xor_b32 s41, s79, s76
  s_bfe_u32 s77, s2, 0x10000
  s_lshl_b32 s77, s77, 17
  s_xor_b32 s41, s41, s77
  s_mov_b32 s27, 0x00020000
  s_mov_b32 s26, 0x80000
  v_lshlrev_b32 v8, 6, v7
  v_xor_b32 v1, v5, v8
  v_xor_b32 v2, 272, v1
  v_xor_b32 v3, 544, v1
  v_xor_b32 v4, 816, v1
  s_lshl_b32 s66, s40, 13
  s_add_u32 s66, s66, 11264
  s_add_u32 s67, s66, 4096
  s_mov_b32 s23, 0x00020000
  s_mov_b32 s22, 0x80000
  s_cmp_eq_u32 s40, 4
  s_waitcnt lgkmcnt(0)
  s_cbranch_scc1 L_helper
  s_add_u32 s24, s8, s47
  s_addc_u32 s25, s9, 0
  buffer_load_dwordx4 v[140:143], v5, s[24:27], s41 offen offset:0 nt
  buffer_load_dwordx4 v[144:147], v5, s[24:27], s41 offen offset:256 nt
  buffer_load_dwordx4 v[148:151], v5, s[24:27], s41 offen offset:512 nt
  buffer_load_dwordx4 v[152:155], v5, s[24:27], s41 offen offset:768 nt
  s_add_u32 s20, s6, s47
  s_addc_u32 s21, s7, 0
  s_mov_b32 m0, s66
  s_nop 0
  buffer_load_dwordx4 v1, s[20:23], s41 offen nt lds
  s_add_u32 m0, s66, 1024
  s_nop 0
  buffer_load_dwordx4 v2, s[20:23], s41 offen nt lds
  s_add_u32 m0, s66, 2048
  s_nop 0
  buffer_load_dwordx4 v3, s[20:23], s41 offen nt lds
  s_add_u32 m0, s66, 3072
  s_nop 0
  buffer_load_dwordx4 v4, s[20:23], s41 offen nt lds
  v_lshlrev_b32 v9, 8, v6
  v_lshl_add_u32 v10, v7, 4, v9
  v_cmp_gt_u32 s[52:53], 4, v6
  s_lshl_b32 s43, s2, 10
  s_mov_b32 s30, 1024
  s_mov_b32 s31, 0x00020000
  v_mov_b64 v[16:17], 0
  v_mov_b64 v[18:19], 0
  v_mov_b64 v[20:21], 0
  v_mov_b64 v[22:23], 0
  v_mov_b64 v[24:25], 0
  v_mov_b64 v[26:27], 0
  v_mov_b64 v[28:29], 0
  v_mov_b64 v[30:31], 0
  s_add_u32 s28, s4, s43
  s_addc_u32 s29, s5, 0
  s_mov_b64 exec, s[52:53]
  buffer_load_dwordx4 v[16:19], v10, s[28:31], 0 offen offset:0
  buffer_load_dwordx4 v[20:23], v10, s[28:31], 0 offen offset:64
  buffer_load_dwordx4 v[24:27], v10, s[28:31], 0 offen offset:128
  buffer_load_dwordx4 v[28:31], v10, s[28:31], 0 offen offset:192
  s_mov_b64 exec, -1
  s_mov_b32 s79, s41
  s_xor_b32 s42, s79, 4096
  s_add_u32 s32, s16, s43
  s_addc_u32 s33, s17, 0
  s_mov_b32 s34, 1024
  s_mov_b32 s35, 0x00020000
  s_mov_b32 s78, 0
  s_add_u32 s78, s78, 16384
  s_xor_b32 s48, s78, s79
  s_xor_b32 s49, s48, 4096
  s_mov_b32 s44, 0x3e0293ee
  s_mov_b32 s45, 0x05040100
  s_mov_b32 s46, 0x07060302
  s_mov_b32 s43, 0
  s_mov_b32 s72, 0
  s_and_b32 s89, s2, 31
  s_or_b32 s89, s89, s40
  s_lshr_b32 s90, s2, 3
  s_and_b32 s90, s90, 28
  s_mov_b32 s36, s18
  s_mov_b32 s37, s19
  s_mov_b32 s38, 256
  s_mov_b32 s93, 0
  s_mov_b32 s94, 870
  s_mov_b32 s39, 0x00020000
  s_mov_b32 s74, 20
  v_xor_b32 v116, v6, v7
  v_lshlrev_b32 v116, 4, v116
  v_and_b32 v12, 3, v0
  v_lshl_add_u32 v116, v12, 10, v116
  v_bfe_u32 v12, v0, 2, 2
  v_lshl_add_u32 v116, v12, 8, v116
  v_add_u32 v116, s66, v116
  v_xor_b32 v117, 64, v116
  v_xor_b32 v118, 128, v116
  v_xor_b32 v119, 192, v116
  v_lshl_add_u32 v12, v6, 2, v7
  v_lshlrev_b32 v12, 7, v12
  s_lshl_b32 s47, s40, 11
  v_add_u32 v12, s47, v12
  v_lshlrev_b32 v15, 3, v6
  s_lshl_b32 s47, s40, 5
  v_add_u32 v13, s47, v15
  v_lshlrev_b32 v14, 7, v7
  v_and_b32 v8, 3, v0
  v_lshl_add_u32 v14, v8, 5, v14
  v_bfe_u32 v8, v0, 2, 2
  v_lshl_add_u32 v14, v8, 2, v14
  s_and_b32 s47, s40, 3
  s_lshl_b32 s47, s47, 9
  v_add_u32 v14, s47, v14
  v_mov_b32 v8, 0xff61b1e6
  v_mov_b32 v68, 0x3f803f80
  v_mov_b32 v69, 0x3f803f80
  v_mov_b32 v70, 0x3f803f80
  v_mov_b32 v71, 0x3f803f80
  v_mov_b64 v[32:33], 0
  v_mov_b64 v[34:35], 0
  v_mov_b64 v[36:37], 0
  v_mov_b64 v[38:39], 0
  v_mov_b64 v[40:41], 0
  v_mov_b64 v[42:43], 0
  v_mov_b64 v[44:45], 0
  v_mov_b64 v[46:47], 0
  v_mov_b64 v[48:49], 0
  v_mov_b64 v[50:51], 0
  v_mov_b64 v[52:53], 0
  v_mov_b64 v[54:55], 0
  v_mov_b64 v[56:57], 0
  v_mov_b64 v[58:59], 0
  v_mov_b64 v[60:61], 0
  v_mov_b64 v[62:63], 0
  v_mov_b64 v[64:65], 0
  v_mov_b64 v[66:67], 0
  s_mov_b32 m0, s67
  s_waitcnt vmcnt(10)
  buffer_load_dwordx4 v1, s[20:23], s42 offen nt lds
  s_add_u32 m0, s67, 1024
  s_waitcnt vmcnt(10)
  buffer_load_dwordx4 v2, s[20:23], s42 offen nt lds
  s_add_u32 m0, s67, 2048
  s_waitcnt vmcnt(10)
  buffer_load_dwordx4 v3, s[20:23], s42 offen nt lds
  s_add_u32 m0, s67, 3072
  s_waitcnt vmcnt(10)
  buffer_load_dwordx4 v4, s[20:23], s42 offen nt lds
  s_waitcnt vmcnt(10)
  buffer_load_dwordx4 v[156:159], v5, s[24:27], s42 offen offset:0 nt
  s_waitcnt vmcnt(10)
  buffer_load_dwordx4 v[160:163], v5, s[24:27], s42 offen offset:256 nt
  s_waitcnt vmcnt(6)
  buffer_load_dwordx4 v[164:167], v5, s[24:27], s42 offen offset:512 nt
  s_waitcnt vmcnt(6)
  buffer_load_dwordx4 v[168:171], v5, s[24:27], s42 offen offset:768 nt
  s_waitcnt vmcnt(8)
  s_branch L_mid
L_loop:
  s_add_u32 s76, s74, 1
  s_lshr_b32 s76, s76, 2
  s_min_u32 s76, s76, 8
  s_cmp_eq_u32 s76, 4
  s_cbranch_scc1 L_g0_d4
  s_cmp_eq_u32 s76, 6
  s_cbranch_scc1 L_g0_d6
  s_cmp_eq_u32 s76, 7
  s_cbranch_scc1 L_g0_d7
  s_cmp_eq_u32 s76, 8
  s_cbranch_scc1 L_g0_d8
  s_mov_b32 m0, s67
  s_waitcnt vmcnt(4)
  buffer_load_dwordx4 v1, s[20:23], s42 offen nt lds
  s_add_u32 m0, s67, 1024
  s_waitcnt vmcnt(4)
  buffer_load_dwordx4 v2, s[20:23], s42 offen nt lds
  s_add_u32 m0, s67, 2048
  s_waitcnt vmcnt(4)
  buffer_load_dwordx4 v3, s[20:23], s42 offen nt lds
  s_add_u32 m0, s67, 3072
  s_waitcnt vmcnt(4)
  buffer_load_dwordx4 v4, s[20:23], s42 offen nt lds
  s_branch L_join0
L_g0_d4:
  s_mov_b32 m0, s67
  s_waitcnt vmcnt(3)
  buffer_load_dwordx4 v1, s[20:23], s42 offen nt lds
  s_add_u32 m0, s67, 1024
  s_waitcnt vmcnt(3)
  buffer_load_dwordx4 v2, s[20:23], s42 offen nt lds
  s_add_u32 m0, s67, 2048
  s_waitcnt vmcnt(3)
  buffer_load_dwordx4 v3, s[20:23], s42 offen nt lds
  s_add_u32 m0, s67, 3072
  s_waitcnt vmcnt(3)
  buffer_load_dwordx4 v4, s[20:23], s42 offen nt lds
  s_branch L_join0
L_g0_d6:
  s_mov_b32 m0, s67
  s_waitcnt vmcnt(5)
  buffer_load_dwordx4 v1, s[20:23], s42 offen nt lds
  s_add_u32 m0, s67, 1024
  s_waitcnt vmcnt(5)
  buffer_load_dwordx4 v2, s[20:23], s42 offen nt lds
  s_add_u32 m0, s67, 2048
  s_waitcnt vmcnt(5)
  buffer_load_dwordx4 v3, s[20:23], s42 offen nt lds
  s_add_u32 m0, s67, 3072
  s_waitcnt vmcnt(5)
  buffer_load_dwordx4 v4, s[20:23], s42 offen nt lds
  s_branch L_join0
L_g0_d7:
  s_mov_b32 m0, s67
  s_waitcnt vmcnt(6)
  buffer_load_dwordx4 v1, s[20:23], s42 offen nt lds
  s_add_u32 m0, s67, 1024
  s_waitcnt vmcnt(6)
  buffer_load_dwordx4 v2, s[20:23], s42 offen nt lds
  s_add_u32 m0, s67, 2048
  s_waitcnt vmcnt(6)
  buffer_load_dwordx4 v3, s[20:23], s42 offen nt lds
  s_add_u32 m0, s67, 3072
  s_waitcnt vmcnt(6)
  buffer_load_dwordx4 v4, s[20:23], s42 offen nt lds
  s_branch L_join0
L_g0_d8:
  s_mov_b32 m0, s67
  s_waitcnt vmcnt(7)
  buffer_load_dwordx4 v1, s[20:23], s42 offen nt lds
  s_add_u32 m0, s67, 1024
  s_waitcnt vmcnt(7)
  buffer_load_dwordx4 v2, s[20:23], s42 offen nt lds
  s_add_u32 m0, s67, 2048
  s_waitcnt vmcnt(7)
  buffer_load_dwordx4 v3, s[20:23], s42 offen nt lds
  s_add_u32 m0, s67, 3072
  s_waitcnt vmcnt(7)
  buffer_load_dwordx4 v4, s[20:23], s42 offen nt lds
L_join0:
L_mid:
  ds_read_b128 v[124:127], v116 offset:0
  ds_read_b128 v[128:131], v117 offset:0
  ds_read_b128 v[132:135], v118 offset:0
  ds_read_b128 v[136:139], v119 offset:0
  s_waitcnt lgkmcnt(3)
  v_mfma_f32_16x16x32_bf16 v[104:107], v[124:127], v[16:19], 0
  s_waitcnt lgkmcnt(2)
  v_mfma_f32_16x16x32_bf16 v[104:107], v[128:131], v[20:23], v[104:107]
  s_waitcnt lgkmcnt(1)
  v_mfma_f32_16x16x32_bf16 v[104:107], v[132:135], v[24:27], v[104:107]
  s_waitcnt lgkmcnt(0)
  v_mfma_f32_16x16x32_bf16 v[104:107], v[136:139], v[28:31], v[104:107]
  s_memrealtime s[68:69]
  s_cmp_eq_u32 s43, 3
  s_cbranch_scc0 L_nold
  s_load_dwordx8 s[80:87], s[18:19], 0
L_nold:
  s_cmp_eq_u32 s43, 7
  s_cbranch_scc0 L_nold2
  s_load_dwordx8 s[80:87], s[18:19], 128
L_nold2:
  s_cmp_eq_u32 s43, 0
  s_cbranch_scc1 L_join1
  s_add_u32 s76, s74, 3
  s_lshr_b32 s76, s76, 2
  s_min_u32 s76, s76, 8
  s_cmp_eq_u32 s76, 4
  s_cbranch_scc1 L_g1_d4
  s_cmp_eq_u32 s76, 6
  s_cbranch_scc1 L_g1_d6
  s_cmp_eq_u32 s76, 7
  s_cbranch_scc1 L_g1_d7
  s_cmp_eq_u32 s76, 8
  s_cbranch_scc1 L_g1_d8
  s_waitcnt vmcnt(4)
  buffer_load_dwordx4 v[156:159], v5, s[24:27], s42 offen offset:0 nt
  s_waitcnt vmcnt(4)
  buffer_load_dwordx4 v[160:163], v5, s[24:27], s42 offen offset:256 nt
  s_waitcnt vmcnt(4)
  buffer_load_dwordx4 v[164:167], v5, s[24:27], s42 offen offset:512 nt
  s_waitcnt vmcnt(4)
  buffer_load_dwordx4 v[168:171], v5, s[24:27], s42 offen offset:768 nt
  s_branch L_join1
L_g1_d4:
  s_waitcnt vmcnt(3)
  buffer_load_dwordx4 v[156:159], v5, s[24:27], s42 offen offset:0 nt
  s_waitcnt vmcnt(3)
  buffer_load_dwordx4 v[160:163], v5, s[24:27], s42 offen offset:256 nt
  s_waitcnt vmcnt(3)
  buffer_load_dwordx4 v[164:167], v5, s[24:27], s42 offen offset:512 nt
  s_waitcnt vmcnt(3)
  buffer_load_dwordx4 v[168:171], v5, s[24:27], s42 offen offset:768 nt
  s_branch L_join1
L_g1_d6:
  s_waitcnt vmcnt(5)
  buffer_load_dwordx4 v[156:159], v5, s[24:27], s42 offen offset:0 nt
  s_waitcnt vmcnt(5)
  buffer_load_dwordx4 v[160:163], v5, s[24:27], s42 offen offset:256 nt
  s_waitcnt vmcnt(5)
  buffer_load_dwordx4 v[164:167], v5, s[24:27], s42 offen offset:512 nt
  s_waitcnt vmcnt(5)
  buffer_load_dwordx4 v[168:171], v5, s[24:27], s42 offen offset:768 nt
  s_branch L_join1
L_g1_d7:
  s_waitcnt vmcnt(6)
  buffer_load_dwordx4 v[156:159], v5, s[24:27], s42 offen offset:0 nt
  s_waitcnt vmcnt(6)
  buffer_load_dwordx4 v[160:163], v5, s[24:27], s42 offen offset:256 nt
  s_waitcnt vmcnt(6)
  buffer_load_dwordx4 v[164:167], v5, s[24:27], s42 offen offset:512 nt
  s_waitcnt vmcnt(6)
  buffer_load_dwordx4 v[168:171], v5, s[24:27], s42 offen offset:768 nt
  s_branch L_join1
L_g1_d8:
  s_waitcnt vmcnt(7)
  buffer_load_dwordx4 v[156:159], v5, s[24:27], s42 offen offset:0 nt
  s_waitcnt vmcnt(7)
  buffer_load_dwordx4 v[160:163], v5, s[24:27], s42 offen offset:256 nt
  s_waitcnt vmcnt(7)
  buffer_load_dwordx4 v[164:167], v5, s[24:27], s42 offen offset:512 nt
  s_waitcnt vmcnt(7)
  buffer_load_dwordx4 v[168:171], v5, s[24:27], s42 offen offset:768 nt
L_join1:
  v_perm_b32 v72, v144, v140, s45
  v_perm_b32 v73, v152, v148, s45
  v_perm_b32 v76, v144, v140, s46
  v_perm_b32 v77, v152, v148, s46
  v_perm_b32 v80, v145, v141, s45
  v_perm_b32 v81, v153, v149, s45
  v_perm_b32 v84, v145, v141, s46
  v_perm_b32 v85, v153, v149, s46
  v_perm_b32 v88, v146, v142, s45
  v_perm_b32 v89, v154, v150, s45
  v_perm_b32 v92, v146, v142, s46
  v_perm_b32 v93, v154, v150, s46
  v_perm_b32 v96, v147, v143, s45
  v_perm_b32 v97, v155, v151, s45
  v_perm_b32 v100, v147, v143, s46
  v_perm_b32 v101, v155, v151, s46
  s_waitcnt lgkmcnt(0)
  s_lshl_b32 s76, s68, 2
  s_cmp_le_u32 s43, 1
  s_cselect_b32 s75, s76, s75
  s_cmp_eq_u32 s43, 1
  s_cbranch_scc0 L_nopubA
  s_mov_b32 s88, s76
  s_cmp_eq_u32 s89, 0
  s_cbranch_scc0 L_nopubA
  v_mov_b32 v121, s76
  s_mov_b64 exec, 1
  buffer_store_dword v121, off, s[36:39], s90 offset:0 sc1
  s_mov_b64 exec, -1
L_nopubA:
  s_cmp_eq_u32 s43, 3
  s_cbranch_scc0 L_noadA
  s_min_u32 s91, s80, s81
  s_min_u32 s91, s91, s82
  s_min_u32 s91, s91, s83
  s_min_u32 s91, s91, s84
  s_min_u32 s91, s91, s85
  s_min_u32 s91, s91, s86
  s_min_u32 s91, s91, s87
  s_cmp_eq_u32 s91, 0
  s_cbranch_scc1 L_noadA
  s_sub_i32 s91, s80, s88
  s_sub_i32 s81, s81, s88
  s_add_i32 s91, s91, s81
  s_sub_i32 s82, s82, s88
  s_add_i32 s91, s91, s82
  s_sub_i32 s83, s83, s88
  s_add_i32 s91, s91, s83
  s_sub_i32 s84, s84, s88
  s_add_i32 s91, s91, s84
  s_sub_i32 s85, s85, s88
  s_add_i32 s91, s91, s85
  s_sub_i32 s86, s86, s88
  s_add_i32 s91, s91, s86
  s_sub_i32 s87, s87, s88
  s_add_i32 s91, s91, s87
  s_ashr_i32 s91, s91, 3
  s_add_u32 s93, s88, s91
  s_sub_i32 s91, s91, 60
  s_min_i32 s91, s91, 300
  s_max_i32 s91, s91, -300
  s_add_u32 s75, s75, s91
L_noadA:
  s_cmp_eq_u32 s43, 5
  s_cbranch_scc0 L_nopubB
  s_mov_b32 s92, s76
  s_cmp_eq_u32 s89, 0
  s_cbranch_scc0 L_nopubB
  v_mov_b32 v121, s76
  s_mov_b64 exec, 1
  buffer_store_dword v121, off, s[36:39], s90 offset:128 sc1
  s_mov_b64 exec, -1
L_nopubB:
  s_cmp_eq_u32 s43, 7
  s_cbranch_scc0 L_noadB
  s_min_u32 s91, s80, s81
  s_min_u32 s91, s91, s82
  s_min_u32 s91, s91, s83
  s_min_u32 s91, s91, s84
  s_min_u32 s91, s91, s85
  s_min_u32 s91, s91, s86
  s_min_u32 s91, s91, s87
  s_cmp_eq_u32 s91, 0
  s_cbranch_scc1 L_noadB
  s_sub_i32 s91, s80, s92
  s_sub_i32 s81, s81, s92
  s_add_i32 s91, s91, s81
  s_sub_i32 s82, s82, s92
  s_add_i32 s91, s91, s82
  s_sub_i32 s83, s83, s92
  s_add_i32 s91, s91, s83
  s_sub_i32 s84, s84, s92
  s_add_i32 s91, s91, s84
  s_sub_i32 s85, s85, s92
  s_add_i32 s91, s91, s85
  s_sub_i32 s86, s86, s92
  s_add_i32 s91, s91, s86
  s_sub_i32 s87, s87, s92
  s_add_i32 s91, s91, s87
  s_ashr_i32 s91, s91, 3
  s_min_i32 s91, s91, 600
  s_max_i32 s91, s91, -600
  s_add_u32 s91, s92, s91
  s_cmp_eq_u32 s93, 0
  s_cbranch_scc1 L_noadB
  s_sub_i32 s94, s91, s93
  s_ashr_i32 s94, s94, 2
  s_sub_i32 s94, s94, 12
  s_max_i32 s94, s94, 870
  s_min_i32 s94, s94, 990
  s_mul_i32 s75, s94, 2
  s_add_u32 s75, s75, s91
  s_sub_u32 s75, s75, 80
L_noadB:
  s_sub_i32 s77, s76, s75
  s_add_u32 s75, s75, s94
  s_add_i32 s77, s77, 1312
  s_ashr_i32 s77, s77, 6
  s_min_i32 s77, s77, 32
  s_max_i32 s74, s77, 16
  s_add_u32 s76, s74, 0
  s_lshr_b32 s76, s76, 2
  s_min_u32 s76, s76, 8
  s_cmp_eq_u32 s76, 4
  s_cbranch_scc1 L_g2_d4
  s_cmp_eq_u32 s76, 6
  s_cbranch_scc1 L_g2_d6
  s_cmp_eq_u32 s76, 7
  s_cbranch_scc1 L_g2_d7
  s_cmp_eq_u32 s76, 8
  s_cbranch_scc1 L_g2_d8
  s_mov_b32 m0, s66
  s_waitcnt vmcnt(4)
  buffer_load_dwordx4 v1, s[20:23], s48 offen nt lds
  s_add_u32 m0, s66, 1024
  s_waitcnt vmcnt(4)
  buffer_load_dwordx4 v2, s[20:23], s48 offen nt lds
  s_add_u32 m0, s66, 2048
  s_waitcnt vmcnt(4)
  buffer_load_dwordx4 v3, s[20:23], s48 offen nt lds
  s_add_u32 m0, s66, 3072
  s_waitcnt vmcnt(4)
  buffer_load_dwordx4 v4, s[20:23], s48 offen nt lds
  s_branch L_join2
L_g2_d4:
  s_mov_b32 m0, s66
  s_waitcnt vmcnt(3)
  buffer_load_dwordx4 v1, s[20:23], s48 offen nt lds
  s_add_u32 m0, s66, 1024
  s_waitcnt vmcnt(3)
  buffer_load_dwordx4 v2, s[20:23], s48 offen nt lds
  s_add_u32 m0, s66, 2048
  s_waitcnt vmcnt(3)
  buffer_load_dwordx4 v3, s[20:23], s48 offen nt lds
  s_add_u32 m0, s66, 3072
  s_waitcnt vmcnt(3)
  buffer_load_dwordx4 v4, s[20:23], s48 offen nt lds
  s_branch L_join2
L_g2_d6:
  s_mov_b32 m0, s66
  s_waitcnt vmcnt(5)
  buffer_load_dwordx4 v1, s[20:23], s48 offen nt lds
  s_add_u32 m0, s66, 1024
  s_waitcnt vmcnt(5)
  buffer_load_dwordx4 v2, s[20:23], s48 offen nt lds
  s_add_u32 m0, s66, 2048
  s_waitcnt vmcnt(5)
  buffer_load_dwordx4 v3, s[20:23], s48 offen nt lds
  s_add_u32 m0, s66, 3072
  s_waitcnt vmcnt(5)
  buffer_load_dwordx4 v4, s[20:23], s48 offen nt lds
  s_branch L_join2
L_g2_d7:
  s_mov_b32 m0, s66
  s_waitcnt vmcnt(6)
  buffer_load_dwordx4 v1, s[20:23], s48 offen nt lds
  s_add_u32 m0, s66, 1024
  s_waitcnt vmcnt(6)
  buffer_load_dwordx4 v2, s[20:23], s48 offen nt lds
  s_add_u32 m0, s66, 2048
  s_waitcnt vmcnt(6)
  buffer_load_dwordx4 v3, s[20:23], s48 offen nt lds
  s_add_u32 m0, s66, 3072
  s_waitcnt vmcnt(6)
  buffer_load_dwordx4 v4, s[20:23], s48 offen nt lds
  s_branch L_join2
L_g2_d8:
  s_mov_b32 m0, s66
  s_waitcnt vmcnt(7)
  buffer_load_dwordx4 v1, s[20:23], s48 offen nt lds
  s_add_u32 m0, s66, 1024
  s_waitcnt vmcnt(7)
  buffer_load_dwordx4 v2, s[20:23], s48 offen nt lds
  s_add_u32 m0, s66, 2048
  s_waitcnt vmcnt(7)
  buffer_load_dwordx4 v3, s[20:23], s48 offen nt lds
  s_add_u32 m0, s66, 3072
  s_waitcnt vmcnt(7)
  buffer_load_dwordx4 v4, s[20:23], s48 offen nt lds
L_join2:
  ds_read_b128 v[124:127], v116 offset:4096
  ds_read_b128 v[128:131], v117 offset:4096
  ds_read_b128 v[132:135], v118 offset:4096
  ds_read_b128 v[136:139], v119 offset:4096
  s_waitcnt lgkmcnt(3)
  v_mfma_f32_16x16x32_bf16 v[108:111], v[124:127], v[16:19], 0
  s_waitcnt lgkmcnt(2)
  v_mfma_f32_16x16x32_bf16 v[108:111], v[128:131], v[20:23], v[108:111]
  s_waitcnt lgkmcnt(1)
  v_mfma_f32_16x16x32_bf16 v[108:111], v[132:135], v[24:27], v[108:111]
  s_waitcnt lgkmcnt(0)
  v_mfma_f32_16x16x32_bf16 v[108:111], v[136:139], v[28:31], v[108:111]
  s_nop 7
  v_max3_f32 v6, v104, v105, v106
  v_max3_f32 v7, v107, v108, v109
  v_max3_f32 v6, v6, v110, v111
  v_max_f32 v6, v6, v7
  v_mov_b32 v7, v6
  s_nop 1
  v_permlane32_swap_b32 v6, v7
  s_nop 1
  v_max_f32 v6, v6, v7
  v_mov_b32 v7, v6
  s_nop 1
  v_permlane16_swap_b32 v6, v7
  s_nop 1
  v_max_f32 v6, v6, v7
  v_mul_f32 v6, s44, v6
  v_cmp_gt_f32 vcc, v6, v8
  s_and_b64 vcc, vcc, s[52:53]
  s_cbranch_scc0 L_nors
  v_max_f32 v6, v6, v8
  v_sub_f32 v10, v8, v6
  v_exp_f32 v10, v10
  v_mov_b32 v8, v6
  v_mul_f32 v64, v64, v10
  v_pk_mul_f32 v[32:33], v[32:33], v[10:11] op_sel_hi:[1,0]
  v_pk_mul_f32 v[34:35], v[34:35], v[10:11] op_sel_hi:[1,0]
  v_pk_mul_f32 v[36:37], v[36:37], v[10:11] op_sel_hi:[1,0]
  v_pk_mul_f32 v[38:39], v[38:39], v[10:11] op_sel_hi:[1,0]
  v_pk_mul_f32 v[40:41], v[40:41], v[10:11] op_sel_hi:[1,0]
  v_pk_mul_f32 v[42:43], v[42:43], v[10:11] op_sel_hi:[1,0]
  v_pk_mul_f32 v[44:45], v[44:45], v[10:11] op_sel_hi:[1,0]
  v_pk_mul_f32 v[46:47], v[46:47], v[10:11] op_sel_hi:[1,0]
  v_pk_mul_f32 v[48:49], v[48:49], v[10:11] op_sel_hi:[1,0]
  v_pk_mul_f32 v[50:51], v[50:51], v[10:11] op_sel_hi:[1,0]
  v_pk_mul_f32 v[52:53], v[52:53], v[10:11] op_sel_hi:[1,0]
  v_pk_mul_f32 v[54:55], v[54:55], v[10:11] op_sel_hi:[1,0]
  v_pk_mul_f32 v[56:57], v[56:57], v[10:11] op_sel_hi:[1,0]
  v_pk_mul_f32 v[58:59], v[58:59], v[10:11] op_sel_hi:[1,0]
  v_pk_mul_f32 v[60:61], v[60:61], v[10:11] op_sel_hi:[1,0]
  v_pk_mul_f32 v[62:63], v[62:63], v[10:11] op_sel_hi:[1,0]
L_nors:
  v_fma_f32 v104, v104, s44, -v8
  v_fma_f32 v105, v105, s44, -v8
  v_fma_f32 v106, v106, s44, -v8
  v_fma_f32 v107, v107, s44, -v8
  v_fma_f32 v108, v108, s44, -v8
  v_fma_f32 v109, v109, s44, -v8
  v_fma_f32 v110, v110, s44, -v8
  v_fma_f32 v111, v111, s44, -v8
  v_exp_f32 v104, v104
  v_exp_f32 v105, v105
  v_exp_f32 v106, v106
  v_exp_f32 v107, v107
  v_exp_f32 v108, v108
  v_exp_f32 v109, v109
  v_exp_f32 v110, v110
  v_exp_f32 v111, v111
  s_nop 0
  v_cvt_pk_bf16_f32 v112, v104, v105
  v_cvt_pk_bf16_f32 v113, v106, v107
  v_cvt_pk_bf16_f32 v114, v108, v109
  v_cvt_pk_bf16_f32 v115, v110, v111
  s_cmp_eq_u32 s43, 14
  s_cbranch_scc1 L_g3_last
  s_add_u32 s76, s74, 2
  s_lshr_b32 s76, s76, 2
  s_min_u32 s76, s76, 8
  s_cmp_eq_u32 s76, 4
  s_cbranch_scc1 L_g3_d4
  s_cmp_eq_u32 s76, 6
  s_cbranch_scc1 L_g3_d6
  s_cmp_eq_u32 s76, 7
  s_cbranch_scc1 L_g3_d7
  s_cmp_eq_u32 s76, 8
  s_cbranch_scc1 L_g3_d8
  s_waitcnt vmcnt(4)
  buffer_load_dwordx4 v[140:143], v5, s[24:27], s48 offen offset:0 nt
  s_waitcnt vmcnt(4)
  buffer_load_dwordx4 v[144:147], v5, s[24:27], s48 offen offset:256 nt
  s_waitcnt vmcnt(4)
  buffer_load_dwordx4 v[148:151], v5, s[24:27], s48 offen offset:512 nt
  s_waitcnt vmcnt(4)
  buffer_load_dwordx4 v[152:155], v5, s[24:27], s48 offen offset:768 nt
  s_branch L_join3
L_g3_d4:
  s_waitcnt vmcnt(3)
  buffer_load_dwordx4 v[140:143], v5, s[24:27], s48 offen offset:0 nt
  s_waitcnt vmcnt(3)
  buffer_load_dwordx4 v[144:147], v5, s[24:27], s48 offen offset:256 nt
  s_waitcnt vmcnt(3)
  buffer_load_dwordx4 v[148:151], v5, s[24:27], s48 offen offset:512 nt
  s_waitcnt vmcnt(3)
  buffer_load_dwordx4 v[152:155], v5, s[24:27], s48 offen offset:768 nt
  s_branch L_join3
L_g3_d6:
  s_waitcnt vmcnt(5)
  buffer_load_dwordx4 v[140:143], v5, s[24:27], s48 offen offset:0 nt
  s_waitcnt vmcnt(5)
  buffer_load_dwordx4 v[144:147], v5, s[24:27], s48 offen offset:256 nt
  s_waitcnt vmcnt(5)
  buffer_load_dwordx4 v[148:151], v5, s[24:27], s48 offen offset:512 nt
  s_waitcnt vmcnt(5)
  buffer_load_dwordx4 v[152:155], v5, s[24:27], s48 offen offset:768 nt
  s_branch L_join3
L_g3_d7:
  s_waitcnt vmcnt(6)
  buffer_load_dwordx4 v[140:143], v5, s[24:27], s48 offen offset:0 nt
  s_waitcnt vmcnt(6)
  buffer_load_dwordx4 v[144:147], v5, s[24:27], s48 offen offset:256 nt
  s_waitcnt vmcnt(6)
  buffer_load_dwordx4 v[148:151], v5, s[24:27], s48 offen offset:512 nt
  s_waitcnt vmcnt(6)
  buffer_load_dwordx4 v[152:155], v5, s[24:27], s48 offen offset:768 nt
  s_branch L_join3
L_g3_d8:
  s_waitcnt vmcnt(7)
  buffer_load_dwordx4 v[140:143], v5, s[24:27], s48 offen offset:0 nt
  s_waitcnt vmcnt(7)
  buffer_load_dwordx4 v[144:147], v5, s[24:27], s48 offen offset:256 nt
  s_waitcnt vmcnt(7)
  buffer_load_dwordx4 v[148:151], v5, s[24:27], s48 offen offset:512 nt
  s_waitcnt vmcnt(7)
  buffer_load_dwordx4 v[152:155], v5, s[24:27], s48 offen offset:768 nt
  s_branch L_join3
L_g3_last:
  s_mov_b32 m0, s67
  s_waitcnt vmcnt(7)
  buffer_load_dwordx4 v1, s[20:23], s49 offen nt lds
  s_add_u32 m0, s67, 1024
  s_waitcnt vmcnt(7)
  buffer_load_dwordx4 v2, s[20:23], s49 offen nt lds
  s_add_u32 m0, s67, 2048
  s_waitcnt vmcnt(7)
  buffer_load_dwordx4 v3, s[20:23], s49 offen nt lds
  s_add_u32 m0, s67, 3072
  s_waitcnt vmcnt(7)
  buffer_load_dwordx4 v4, s[20:23], s49 offen nt lds
L_join3:
  v_mfma_f32_16x16x32_bf16 v[64:67], v[68:71], v[112:115], v[64:67]
  v_perm_b32 v74, v160, v156, s45
  v_perm_b32 v75, v168, v164, s45
  v_perm_b32 v78, v160, v156, s46
  v_perm_b32 v79, v168, v164, s46
  v_perm_b32 v82, v161, v157, s45
  v_perm_b32 v83, v169, v165, s45
  v_perm_b32 v86, v161, v157, s46
  v_perm_b32 v87, v169, v165, s46
  v_mfma_f32_16x16x32_bf16 v[32:35], v[72:75], v[112:115], v[32:35]
  v_mfma_f32_16x16x32_bf16 v[36:39], v[76:79], v[112:115], v[36:39]
  v_perm_b32 v90, v162, v158, s45
  v_perm_b32 v91, v170, v166, s45
  v_perm_b32 v94, v162, v158, s46
  v_perm_b32 v95, v170, v166, s46
  v_mfma_f32_16x16x32_bf16 v[40:43], v[80:83], v[112:115], v[40:43]
  v_mfma_f32_16x16x32_bf16 v[44:47], v[84:87], v[112:115], v[44:47]
  v_perm_b32 v98, v163, v159, s45
  v_perm_b32 v99, v171, v167, s45
  v_perm_b32 v102, v163, v159, s46
  v_perm_b32 v103, v171, v167, s46
  v_mfma_f32_16x16x32_bf16 v[48:51], v[88:91], v[112:115], v[48:51]
  v_mfma_f32_16x16x32_bf16 v[52:55], v[92:95], v[112:115], v[52:55]
  s_mov_b32 s41, s48
  s_mov_b32 s42, s49
  v_mfma_f32_16x16x32_bf16 v[56:59], v[96:99], v[112:115], v[56:59]
  v_mfma_f32_16x16x32_bf16 v[60:63], v[100:103], v[112:115], v[60:63]
  s_add_u32 s78, s78, 16384
  s_xor_b32 s48, s78, s79
  s_xor_b32 s49, s48, 4096
  s_add_u32 s43, s43, 1
  s_cmp_lt_u32 s43, 15
  s_cbranch_scc1 L_loop
  s_waitcnt vmcnt(7)
  buffer_load_dwordx4 v[140:143], v5, s[24:27], s41 offen offset:0 nt
  s_waitcnt vmcnt(7)
  buffer_load_dwordx4 v[144:147], v5, s[24:27], s41 offen offset:256 nt
  s_waitcnt vmcnt(7)
  buffer_load_dwordx4 v[148:151], v5, s[24:27], s41 offen offset:512 nt
  s_waitcnt vmcnt(7)
  buffer_load_dwordx4 v[152:155], v5, s[24:27], s41 offen offset:768 nt
L_tail:
  ds_read_b128 v[124:127], v116 offset:0
  ds_read_b128 v[128:131], v117 offset:0
  ds_read_b128 v[132:135], v118 offset:0
  ds_read_b128 v[136:139], v119 offset:0
  s_waitcnt lgkmcnt(3)
  v_mfma_f32_16x16x32_bf16 v[104:107], v[124:127], v[16:19], 0
  s_waitcnt lgkmcnt(2)
  v_mfma_f32_16x16x32_bf16 v[104:107], v[128:131], v[20:23], v[104:107]
  s_waitcnt lgkmcnt(1)
  v_mfma_f32_16x16x32_bf16 v[104:107], v[132:135], v[24:27], v[104:107]
  s_waitcnt lgkmcnt(0)
  v_mfma_f32_16x16x32_bf16 v[104:107], v[136:139], v[28:31], v[104:107]
  s_waitcnt vmcnt(7)
  buffer_load_dwordx4 v[156:159], v5, s[24:27], s42 offen offset:0 nt
  s_waitcnt vmcnt(7)
  buffer_load_dwordx4 v[160:163], v5, s[24:27], s42 offen offset:256 nt
  s_waitcnt vmcnt(7)
  buffer_load_dwordx4 v[164:167], v5, s[24:27], s42 offen offset:512 nt
  s_waitcnt vmcnt(7)
  buffer_load_dwordx4 v[168:171], v5, s[24:27], s42 offen offset:768 nt
L_tail2:
  ds_read_b128 v[124:127], v116 offset:4096
  ds_read_b128 v[128:131], v117 offset:4096
  ds_read_b128 v[132:135], v118 offset:4096
  ds_read_b128 v[136:139], v119 offset:4096
  s_waitcnt lgkmcnt(3)
  v_mfma_f32_16x16x32_bf16 v[108:111], v[124:127], v[16:19], 0
  s_waitcnt lgkmcnt(2)
  v_mfma_f32_16x16x32_bf16 v[108:111], v[128:131], v[20:23], v[108:111]
  s_waitcnt lgkmcnt(1)
  v_mfma_f32_16x16x32_bf16 v[108:111], v[132:135], v[24:27], v[108:111]
  s_waitcnt lgkmcnt(0)
  v_mfma_f32_16x16x32_bf16 v[108:111], v[136:139], v[28:31], v[108:111]
  s_nop 7
  v_max3_f32 v6, v104, v105, v106
  v_max3_f32 v7, v107, v108, v109
  v_max3_f32 v6, v6, v110, v111
  v_max_f32 v6, v6, v7
  v_mov_b32 v7, v6
  s_nop 1
  v_permlane32_swap_b32 v6, v7
  s_nop 1
  v_max_f32 v6, v6, v7
  v_mov_b32 v7, v6
  s_nop 1
  v_permlane16_swap_b32 v6, v7
  s_nop 1
  v_max_f32 v6, v6, v7
  v_mul_f32 v6, s44, v6
  v_cmp_gt_f32 vcc, v6, v8
  s_and_b64 vcc, vcc, s[52:53]
  s_cbranch_scc0 L_norsT
  v_max_f32 v6, v6, v8
  v_sub_f32 v10, v8, v6
  v_exp_f32 v10, v10
  v_mov_b32 v8, v6
  v_mul_f32 v64, v64, v10
  v_pk_mul_f32 v[32:33], v[32:33], v[10:11] op_sel_hi:[1,0]
  v_pk_mul_f32 v[34:35], v[34:35], v[10:11] op_sel_hi:[1,0]
  v_pk_mul_f32 v[36:37], v[36:37], v[10:11] op_sel_hi:[1,0]
  v_pk_mul_f32 v[38:39], v[38:39], v[10:11] op_sel_hi:[1,0]
  v_pk_mul_f32 v[40:41], v[40:41], v[10:11] op_sel_hi:[1,0]
  v_pk_mul_f32 v[42:43], v[42:43], v[10:11] op_sel_hi:[1,0]
  v_pk_mul_f32 v[44:45], v[44:45], v[10:11] op_sel_hi:[1,0]
  v_pk_mul_f32 v[46:47], v[46:47], v[10:11] op_sel_hi:[1,0]
  v_pk_mul_f32 v[48:49], v[48:49], v[10:11] op_sel_hi:[1,0]
  v_pk_mul_f32 v[50:51], v[50:51], v[10:11] op_sel_hi:[1,0]
  v_pk_mul_f32 v[52:53], v[52:53], v[10:11] op_sel_hi:[1,0]
  v_pk_mul_f32 v[54:55], v[54:55], v[10:11] op_sel_hi:[1,0]
  v_pk_mul_f32 v[56:57], v[56:57], v[10:11] op_sel_hi:[1,0]
  v_pk_mul_f32 v[58:59], v[58:59], v[10:11] op_sel_hi:[1,0]
  v_pk_mul_f32 v[60:61], v[60:61], v[10:11] op_sel_hi:[1,0]
  v_pk_mul_f32 v[62:63], v[62:63], v[10:11] op_sel_hi:[1,0]
L_norsT:
  v_fma_f32 v104, v104, s44, -v8
  v_fma_f32 v105, v105, s44, -v8
  v_fma_f32 v106, v106, s44, -v8
  v_fma_f32 v107, v107, s44, -v8
  v_fma_f32 v108, v108, s44, -v8
  v_fma_f32 v109, v109, s44, -v8
  v_fma_f32 v110, v110, s44, -v8
  v_fma_f32 v111, v111, s44, -v8
  v_exp_f32 v104, v104
  v_exp_f32 v105, v105
  v_exp_f32 v106, v106
  v_exp_f32 v107, v107
  v_exp_f32 v108, v108
  v_exp_f32 v109, v109
  v_exp_f32 v110, v110
  v_exp_f32 v111, v111
  s_nop 0
  v_cvt_pk_bf16_f32 v112, v104, v105
  v_cvt_pk_bf16_f32 v113, v106, v107
  v_cvt_pk_bf16_f32 v114, v108, v109
  v_cvt_pk_bf16_f32 v115, v110, v111
  s_nop 1
  v_mfma_f32_16x16x32_bf16 v[64:67], v[68:71], v[112:115], v[64:67]
  s_nop 6
L_xchg:
  s_mov_b64 exec, s[52:53]
  v_mov_b32 v10, v8
  v_mov_b32 v11, v64
  ds_write_b64 v13, v[10:11] offset:10240
  s_mov_b64 exec, -1
  s_waitcnt lgkmcnt(0)
  s_barrier
L_w2:
  ds_read_b64 v[16:17], v15 offset:10240
  ds_read_b64 v[18:19], v15 offset:10272
  ds_read_b64 v[20:21], v15 offset:10304
  ds_read_b64 v[22:23], v15 offset:10336
  ds_read_b64 v[24:25], v15 offset:10368
  s_lshl_b32 s47, s40, 8
  s_waitcnt lgkmcnt(0)
  v_max3_f32 v6, v16, v18, v20
  v_max3_f32 v6, v6, v22, v24
  v_sub_f32 v10, v8, v6
  v_sub_f32 v16, v16, v6
  v_sub_f32 v18, v18, v6
  v_sub_f32 v20, v20, v6
  v_sub_f32 v22, v22, v6
  v_sub_f32 v24, v24, v6
  v_exp_f32 v10, v10
  v_exp_f32 v16, v16
  v_exp_f32 v18, v18
  v_exp_f32 v20, v20
  v_exp_f32 v22, v22
  v_exp_f32 v24, v24
  s_nop 0
  v_mul_f32 v7, v16, v17
  v_fmac_f32 v7, v18, v19
  v_fmac_f32 v7, v20, v21
  v_fmac_f32 v7, v22, v23
  v_fmac_f32 v7, v24, v25
  v_rcp_f32 v7, v7
  s_cmp_eq_u32 s72, 2
  v_mul_f32 v10, v10, v7
  v_pk_mul_f32 v[32:33], v[32:33], v[10:11] op_sel_hi:[1,0]
  v_pk_mul_f32 v[34:35], v[34:35], v[10:11] op_sel_hi:[1,0]
  v_pk_mul_f32 v[36:37], v[36:37], v[10:11] op_sel_hi:[1,0]
  v_pk_mul_f32 v[38:39], v[38:39], v[10:11] op_sel_hi:[1,0]
  v_pk_mul_f32 v[40:41], v[40:41], v[10:11] op_sel_hi:[1,0]
  v_pk_mul_f32 v[42:43], v[42:43], v[10:11] op_sel_hi:[1,0]
  v_pk_mul_f32 v[44:45], v[44:45], v[10:11] op_sel_hi:[1,0]
  v_pk_mul_f32 v[46:47], v[46:47], v[10:11] op_sel_hi:[1,0]
  v_pk_mul_f32 v[48:49], v[48:49], v[10:11] op_sel_hi:[1,0]
  v_pk_mul_f32 v[50:51], v[50:51], v[10:11] op_sel_hi:[1,0]
  v_pk_mul_f32 v[52:53], v[52:53], v[10:11] op_sel_hi:[1,0]
  v_pk_mul_f32 v[54:55], v[54:55], v[10:11] op_sel_hi:[1,0]
  v_pk_mul_f32 v[56:57], v[56:57], v[10:11] op_sel_hi:[1,0]
  v_pk_mul_f32 v[58:59], v[58:59], v[10:11] op_sel_hi:[1,0]
  v_pk_mul_f32 v[60:61], v[60:61], v[10:11] op_sel_hi:[1,0]
  v_pk_mul_f32 v[62:63], v[62:63], v[10:11] op_sel_hi:[1,0]
  s_cbranch_scc1 L_wr
  v_pk_mul_f32 v[104:105], v[104:105], v[10:11] op_sel_hi:[1,0]
  v_pk_mul_f32 v[106:107], v[106:107], v[10:11] op_sel_hi:[1,0]
  v_pk_mul_f32 v[108:109], v[108:109], v[10:11] op_sel_hi:[1,0]
  v_pk_mul_f32 v[110:111], v[110:111], v[10:11] op_sel_hi:[1,0]
  v_cvt_pk_bf16_f32 v112, v104, v105
  v_cvt_pk_bf16_f32 v113, v106, v107
  v_cvt_pk_bf16_f32 v114, v108, v109
  v_cvt_pk_bf16_f32 v115, v110, v111
  s_waitcnt vmcnt(4)
  v_perm_b32 v72, v144, v140, s45
  v_perm_b32 v73, v152, v148, s45
  v_perm_b32 v76, v144, v140, s46
  v_perm_b32 v77, v152, v148, s46
  v_perm_b32 v80, v145, v141, s45
  v_perm_b32 v81, v153, v149, s45
  v_perm_b32 v84, v145, v141, s46
  v_perm_b32 v85, v153, v149, s46
  v_perm_b32 v88, v146, v142, s45
  v_perm_b32 v89, v154, v150, s45
  v_perm_b32 v92, v146, v142, s46
  v_perm_b32 v93, v154, v150, s46
  v_perm_b32 v96, v147, v143, s45
  v_perm_b32 v97, v155, v151, s45
  v_perm_b32 v100, v147, v143, s46
  v_perm_b32 v101, v155, v151, s46
  v_lshlrev_b32 v6, 2, v0
  s_waitcnt vmcnt(0)
  v_perm_b32 v74, v160, v156, s45
  v_perm_b32 v75, v168, v164, s45
  v_perm_b32 v78, v160, v156, s46
  v_perm_b32 v79, v168, v164, s46
  v_perm_b32 v82, v161, v157, s45
  v_perm_b32 v83, v169, v165, s45
  v_perm_b32 v86, v161, v157, s46
  v_perm_b32 v87, v169, v165, s46
  v_mfma_f32_16x16x32_bf16 v[32:35], v[72:75], v[112:115], v[32:35]
  v_mfma_f32_16x16x32_bf16 v[36:39], v[76:79], v[112:115], v[36:39]
  v_perm_b32 v90, v162, v158, s45
  v_perm_b32 v91, v170, v166, s45
  v_perm_b32 v94, v162, v158, s46
  v_perm_b32 v95, v170, v166, s46
  v_mfma_f32_16x16x32_bf16 v[40:43], v[80:83], v[112:115], v[40:43]
  v_mfma_f32_16x16x32_bf16 v[44:47], v[84:87], v[112:115], v[44:47]
  v_perm_b32 v98, v163, v159, s45
  v_perm_b32 v99, v171, v167, s45
  v_perm_b32 v102, v163, v159, s46
  v_perm_b32 v103, v171, v167, s46
  v_mfma_f32_16x16x32_bf16 v[48:51], v[88:91], v[112:115], v[48:51]
  v_mfma_f32_16x16x32_bf16 v[52:55], v[92:95], v[112:115], v[52:55]
  s_nop 1
  v_mfma_f32_16x16x32_bf16 v[56:59], v[96:99], v[112:115], v[56:59]
  v_mfma_f32_16x16x32_bf16 v[60:63], v[100:103], v[112:115], v[60:63]
L_wr:
  s_mov_b64 exec, s[52:53]
  s_cmp_eq_u32 s72, 2
  ds_write_b128 v12, v[32:35] offset:0
  ds_write_b128 v12, v[36:39] offset:16
  ds_write_b128 v12, v[40:43] offset:32
  ds_write_b128 v12, v[44:47] offset:48
  s_nop 1
  ds_write_b128 v12, v[48:51] offset:64
  ds_write_b128 v12, v[52:55] offset:80
  ds_write_b128 v12, v[56:59] offset:96
  ds_write_b128 v12, v[60:63] offset:112
  s_mov_b64 exec, -1
  s_waitcnt lgkmcnt(0)
  s_barrier
  s_cbranch_scc1 L_end
L_sum:
  ds_read2_b32 v[16:17], v14 offset0:0 offset1:4
  ds_read_b32 v18, v14 offset:2048
  ds_read_b32 v19, v14 offset:2064
  ds_read_b32 v20, v14 offset:4096
  ds_read_b32 v21, v14 offset:4112
  ds_read_b32 v22, v14 offset:6144
  ds_read_b32 v23, v14 offset:6160
  ds_read_b32 v24, v14 offset:8192
  ds_read_b32 v25, v14 offset:8208
  s_waitcnt lgkmcnt(4)
  v_pk_add_f32 v[16:17], v[16:17], v[18:19]
  v_pk_add_f32 v[16:17], v[16:17], v[20:21]
  s_waitcnt lgkmcnt(0)
  v_pk_add_f32 v[22:23], v[22:23], v[24:25]
  v_pk_add_f32 v[16:17], v[16:17], v[22:23]
  v_cvt_pk_bf16_f32 v16, v16, v17
  buffer_store_dword v16, v6, s[32:35], s47 offen sc1
L_end:
  s_endpgm
L_helper:
  v_lshlrev_b32 v9, 8, v6
  v_lshl_add_u32 v10, v7, 4, v9
  v_cmp_gt_u32 s[52:53], 4, v6
  s_lshl_b32 s43, s2, 10
  s_mov_b32 s30, 1024
  s_mov_b32 s31, 0x00020000
  v_mov_b64 v[16:17], 0
  v_mov_b64 v[18:19], 0
  v_mov_b64 v[20:21], 0
  v_mov_b64 v[22:23], 0
  v_mov_b64 v[24:25], 0
  v_mov_b64 v[26:27], 0
  v_mov_b64 v[28:29], 0
  v_mov_b64 v[30:31], 0
  s_add_u32 s28, s4, s43
  s_addc_u32 s29, s5, 0
  v_mov_b32 v1, v10
  v_lshlrev_b32 v2, 6, v7
  v_lshl_add_u32 v12, v6, 2, v7
  v_lshlrev_b32 v12, 7, v12
  s_lshl_b32 s47, s40, 11
  v_add_u32 v12, s47, v12
  v_lshlrev_b32 v15, 3, v6
  s_lshl_b32 s47, s40, 5
  v_add_u32 v13, s47, v15
  v_lshlrev_b32 v14, 7, v7
  v_and_b32 v8, 3, v0
  v_lshl_add_u32 v14, v8, 5, v14
  v_bfe_u32 v8, v0, 2, 2
  v_lshl_add_u32 v14, v8, 2, v14
  s_and_b32 s47, s40, 3
  s_lshl_b32 s47, s47, 9
  v_add_u32 v14, s47, v14
  s_mov_b32 s44, 0x3e0293ee
L_help2:
  s_mov_b32 s72, 2
  s_mov_b64 exec, s[52:53]
  buffer_load_dwordx4 v[16:19], v10, s[28:31], 0 offen offset:0
  buffer_load_dwordx4 v[20:23], v10, s[28:31], 0 offen offset:64
  buffer_load_dwordx4 v[24:27], v10, s[28:31], 0 offen offset:128
  buffer_load_dwordx4 v[28:31], v10, s[28:31], 0 offen offset:192
  s_mov_b64 exec, -1
  s_lshl_b32 s47, s2, 8
  s_add_u32 s36, s10, s47
  s_addc_u32 s37, s11, 0
  s_mov_b32 s38, 256
  s_mov_b32 s39, 0x00020000
  buffer_load_dwordx4 v[72:75], v10, s[36:39], 0 offen offset:0
  buffer_load_dwordx4 v[76:79], v10, s[36:39], 0 offen offset:64
  buffer_load_dwordx4 v[80:83], v10, s[36:39], 0 offen offset:128
  buffer_load_dwordx4 v[84:87], v10, s[36:39], 0 offen offset:192
  s_add_u32 s36, s12, s47
  s_addc_u32 s37, s13, 0
  buffer_load_dwordx4 v[88:91], v2, s[36:39], 0 offen offset:0
  buffer_load_dwordx4 v[92:95], v2, s[36:39], 0 offen offset:16
  buffer_load_dwordx4 v[96:99], v2, s[36:39], 0 offen offset:32
  buffer_load_dwordx4 v[100:103], v2, s[36:39], 0 offen offset:48
  s_mov_b32 s36, s14
  s_mov_b32 s37, s15
  s_mov_b32 s38, 64
  s_lshr_b32 s47, s2, 3
  s_lshl_b32 s47, s47, 1
  buffer_load_ushort v9, off, s[36:39], s47
  v_mov_b32 v8, 0xff61b1e6
  s_waitcnt vmcnt(0)
  v_mfma_f32_16x16x32_bf16 v[104:107], v[72:75], v[16:19], 0
  v_mfma_f32_16x16x32_bf16 v[104:107], v[76:79], v[20:23], v[104:107]
  v_mfma_f32_16x16x32_bf16 v[104:107], v[80:83], v[24:27], v[104:107]
  v_mfma_f32_16x16x32_bf16 v[104:107], v[84:87], v[28:31], v[104:107]
  v_lshlrev_b32 v32, 16, v88
  v_and_b32 v36, 0xffff0000, v88
  v_lshlrev_b32 v40, 16, v89
  v_and_b32 v44, 0xffff0000, v89
  v_lshlrev_b32 v48, 16, v90
  v_and_b32 v52, 0xffff0000, v90
  v_lshlrev_b32 v56, 16, v91
  v_and_b32 v60, 0xffff0000, v91
  v_lshlrev_b32 v33, 16, v92
  v_and_b32 v37, 0xffff0000, v92
  v_lshlrev_b32 v41, 16, v93
  v_and_b32 v45, 0xffff0000, v93
  v_lshlrev_b32 v49, 16, v94
  v_and_b32 v53, 0xffff0000, v94
  v_lshlrev_b32 v57, 16, v95
  v_and_b32 v61, 0xffff0000, v95
  v_lshlrev_b32 v34, 16, v96
  v_and_b32 v38, 0xffff0000, v96
  v_lshlrev_b32 v42, 16, v97
  v_and_b32 v46, 0xffff0000, v97
  v_lshlrev_b32 v50, 16, v98
  v_and_b32 v54, 0xffff0000, v98
  v_lshlrev_b32 v58, 16, v99
  v_and_b32 v62, 0xffff0000, v99
  v_lshlrev_b32 v35, 16, v100
  v_and_b32 v39, 0xffff0000, v100
  v_lshlrev_b32 v43, 16, v101
  v_and_b32 v47, 0xffff0000, v101
  v_lshlrev_b32 v51, 16, v102
  v_and_b32 v55, 0xffff0000, v102
  v_lshlrev_b32 v59, 16, v103
  v_and_b32 v63, 0xffff0000, v103
  v_lshlrev_b32 v9, 16, v9
  v_sub_f32 v9, 1.0, v9
  v_mul_f32 v9, 0xceabfb8f, v9
  v_fma_f32 v6, v104, s44, v9
  v_cmp_gt_u32 vcc, 16, v0
  v_mov_b32 v64, 1.0
  s_nop 0
  v_cndmask_b32 v8, v8, v6, vcc
  v_mov_b32 v6, v8
  s_nop 1
  v_permlane32_swap_b32 v8, v6
  s_nop 1
  v_max_f32 v8, v8, v6
  v_mov_b32 v6, v8
  s_nop 1
  v_permlane16_swap_b32 v8, v6
  s_nop 1
  v_max_f32 v8, v8, v6
  s_branch L_xchg
.section .rodata,"a"
.p2align 6
.amdhsa_kernel standalone__tree_speculative_verify_tree_attention_over_candidate_token_tree__sampling_kernel
  .amdhsa_next_free_vgpr 172
  .amdhsa_next_free_sgpr 96
  .amdhsa_accum_offset 172
  .amdhsa_group_segment_fixed_size 0
  .amdhsa_kernarg_size 72
  .amdhsa_user_sgpr_count 2
  .amdhsa_user_sgpr_kernarg_segment_ptr 1
  .amdhsa_system_sgpr_workgroup_id_x 1
.end_amdhsa_kernel
```
